```python
import torch

def _softmax(x, axis=-1):
    return torch.softmax(x, dim=axis)
def _gelu(x):
    return torch.nn.functional.gelu(x, approximate="tanh")
def _silu(x):
    return torch.nn.functional.silu(x)
def _sigmoid(x):
    return torch.sigmoid(x)
def _layernorm(x, axis=-1, eps=1e-5):
    m = x.mean(dim=axis, keepdim=True)
    v = x.var(dim=axis, keepdim=True, unbiased=False)
    return (x - m) / torch.sqrt(v + eps)
def _scatter_add(tgt, idx, src, axis=0):
    return tgt.clone().index_add_(axis, idx, src)
def _segment_sum(src, seg, n):
    out = torch.zeros((n,) + src.shape[1:], dtype=src.dtype)
    return out.index_add_(0, seg, src)
def _pad(x, pw):
    flat = tuple(v for pair in reversed(pw) for v in pair)
    return torch.nn.functional.pad(x, flat)

kernel_name = 'standalone__fm_second_order__recsys'

def setup_inputs():

    _w = (lambda a: (lambda t: t.to(torch.bfloat16) if t.is_floating_point() else t)(torch.as_tensor(a)))
    B, F, D, V = 4096, 26, 128, min(1000000, 100000)
    return {
        "idx": _w((lambda lo, hi, *s: torch.randint(lo, hi, s))(0, V, B, F).to(torch.int64)),
        "table": _w((lambda *s: torch.randn(*s, dtype=torch.bfloat16) * 0.05)(V, D)),
    }

def reference(idx, table):
    emb = table[idx]
    sum_sq = emb.sum(axis=1) ** 2
    sq_sum = (emb ** 2).sum(axis=1)
    return 0.5 * (sum_sq - sq_sum).sum(axis=-1)
```

```asm
; @launch grid=(256,1,1) block=(1024,1,1) lds=0
.amdgcn_target "amdgcn-amd-amdhsa--gfx950"
.text
.globl standalone__fm_second_order__recsys_kernel
.p2align 8
.type standalone__fm_second_order__recsys_kernel,@function
standalone__fm_second_order__recsys_kernel:
    s_load_dwordx2 s[4:5], s[0:1], 0
    s_load_dwordx2 s[8:9], s[0:1], 8
    s_load_dwordx2 s[12:13], s[0:1], 16
    s_cmp_ge_u32 s2, 256
    s_cbranch_scc1 L_done
    s_and_b32 s3, s2, 7
    s_lshr_b32 s2, s2, 3
    s_lshl_b32 s3, s3, 5
    s_add_u32 s2, s2, s3
    v_lshrrev_b32 v3, 6, v0
    v_and_b32 v20, 7, v0
    v_bfe_u32 v21, v0, 4, 2
    v_bfe_u32 v22, v0, 5, 1
    v_cmp_eq_u32 vcc, 6, v20
    v_mul_u32_u24 v2, 104, v3
    v_lshl_add_u32 v2, v20, 4, v2
    v_cndmask_b32 v21, v21, v22, vcc
    v_lshl_add_u32 v2, v21, 2, v2
    s_mov_b32 s6, 425984
    s_mov_b32 s7, 0x00020000
    s_mul_i32 s3, s2, 1664
    s_mov_b32 s10, 25600000
    s_mov_b32 s11, 0x00020000
    s_waitcnt lgkmcnt(0)
    buffer_load_dword v10, v2, s[4:7], s3 offen
    s_mov_b32 s14, 8192
    s_mov_b32 s15, 0x00020000
    s_lshl_b32 s18, s2, 5
    s_mov_b32 s16, 0xbf803f80
    s_mov_b32 s17, 0x3f003f00
    s_mov_b32 s19, 0xffff0000
    v_lshlrev_b32 v3, 1, v3
    v_and_b32 v20, 15, v0
    v_lshlrev_b32 v1, 4, v20
    v_bfe_u32 v22, v0, 4, 1
    v_lshl_add_u32 v11, v22, 3, v1
    v_and_b32 v20, 1, v0
    v_lshlrev_b32 v20, 4, v20
    v_mov_b32 v21, 0x3f80
    v_lshlrev_b32 v20, v20, v21
    v_bfe_u32 v21, v0, 1, 3
    v_lshlrev_b32 v22, 1, v22
    v_sub_u32 v22, v21, v22
    v_cmp_eq_u32 s[22:23], 0, v21
    v_cmp_eq_u32 s[24:25], 1, v21
    v_cmp_eq_u32 s[26:27], 2, v21
    v_cmp_eq_u32 s[28:29], 3, v21
    v_cmp_eq_u32 vcc, 0, v22
    v_mov_b32 v12, 0
    v_mov_b32 v13, 0
    v_mov_b32 v14, 0
    v_mov_b32 v15, 0
    v_mov_b32 v16, 0
    v_mov_b32 v17, 0
    v_mov_b32 v18, 0
    v_mov_b32 v19, 0
    v_cndmask_b32 v8, 0, v20, vcc
    v_cmp_eq_u32 vcc, 1, v22
    v_cndmask_b32 v4, 0, v20, s[22:23]
    v_cndmask_b32 v5, 0, v20, s[24:25]
    v_cndmask_b32 v6, 0, v20, s[26:27]
    v_cndmask_b32 v7, 0, v20, s[28:29]
    v_cndmask_b32 v9, 0, v20, vcc
    s_waitcnt vmcnt(0)
    v_add_u32 v20, 100000, v10
    v_min_u32 v10, v10, v20
    v_lshlrev_b32 v10, 8, v10
    s_nop 1
    v_add_u32_dpp v28, v10, v1 row_newbcast:0 row_mask:0xf bank_mask:0xf
    buffer_load_dwordx4 v[28:31], v28, s[8:11], 0 offen
    v_add_u32_dpp v32, v10, v1 row_newbcast:1 row_mask:0xf bank_mask:0xf
    buffer_load_dwordx4 v[32:35], v32, s[8:11], 0 offen
    v_add_u32_dpp v36, v10, v1 row_newbcast:2 row_mask:0xf bank_mask:0xf
    buffer_load_dwordx4 v[36:39], v36, s[8:11], 0 offen
    v_add_u32_dpp v40, v10, v1 row_newbcast:3 row_mask:0xf bank_mask:0xf
    buffer_load_dwordx4 v[40:43], v40, s[8:11], 0 offen
    v_add_u32_dpp v44, v10, v1 row_newbcast:4 row_mask:0xf bank_mask:0xf
    buffer_load_dwordx4 v[44:47], v44, s[8:11], 0 offen
    v_add_u32_dpp v48, v10, v1 row_newbcast:5 row_mask:0xf bank_mask:0xf
    buffer_load_dwordx4 v[48:51], v48, s[8:11], 0 offen
    v_add_u32_dpp v52, v10, v11 row_newbcast:6 row_mask:0xf bank_mask:0xf
    buffer_load_dwordx2 v[52:53], v52, s[8:11], 0 offen
    s_waitcnt vmcnt(6)
    v_mfma_f32_16x16x32_bf16 v[12:15], v[4:7], v[28:31], v[12:15]
    v_lshlrev_b32 v20, 16, v28
    v_and_b32 v21, s19, v28
    v_lshlrev_b32 v22, 16, v29
    v_and_b32 v23, s19, v29
    v_lshlrev_b32 v24, 16, v30
    v_and_b32 v25, s19, v30
    v_lshlrev_b32 v26, 16, v31
    v_and_b32 v27, s19, v31
    v_pk_mul_f32 v[20:21], v[20:21], v[20:21]
    v_pk_mul_f32 v[22:23], v[22:23], v[22:23]
    v_pk_mul_f32 v[24:25], v[24:25], v[24:25]
    v_pk_mul_f32 v[26:27], v[26:27], v[26:27]
    v_cvt_pk_bf16_f32 v28, v20, v21
    v_cvt_pk_bf16_f32 v29, v22, v23
    v_cvt_pk_bf16_f32 v30, v24, v25
    v_cvt_pk_bf16_f32 v31, v26, v27
    s_waitcnt vmcnt(5)
    v_mfma_f32_16x16x32_bf16 v[12:15], v[4:7], v[32:35], v[12:15]
    v_lshlrev_b32 v20, 16, v32
    v_and_b32 v21, s19, v32
    v_mfma_f32_16x16x32_bf16 v[16:19], v[4:7], v[28:31], v[16:19]
    v_lshlrev_b32 v22, 16, v33
    v_and_b32 v23, s19, v33
    v_lshlrev_b32 v24, 16, v34
    v_and_b32 v25, s19, v34
    v_lshlrev_b32 v26, 16, v35
    v_and_b32 v27, s19, v35
    v_pk_mul_f32 v[20:21], v[20:21], v[20:21]
    v_pk_mul_f32 v[22:23], v[22:23], v[22:23]
    v_pk_mul_f32 v[24:25], v[24:25], v[24:25]
    v_pk_mul_f32 v[26:27], v[26:27], v[26:27]
    v_cvt_pk_bf16_f32 v32, v20, v21
    v_cvt_pk_bf16_f32 v33, v22, v23
    v_cvt_pk_bf16_f32 v34, v24, v25
    v_cvt_pk_bf16_f32 v35, v26, v27
    s_waitcnt vmcnt(4)
    v_mfma_f32_16x16x32_bf16 v[12:15], v[4:7], v[36:39], v[12:15]
    v_lshlrev_b32 v20, 16, v36
    v_and_b32 v21, s19, v36
    v_mfma_f32_16x16x32_bf16 v[16:19], v[4:7], v[32:35], v[16:19]
    v_lshlrev_b32 v22, 16, v37
    v_and_b32 v23, s19, v37
    v_lshlrev_b32 v24, 16, v38
    v_and_b32 v25, s19, v38
    v_lshlrev_b32 v26, 16, v39
    v_and_b32 v27, s19, v39
    v_pk_mul_f32 v[20:21], v[20:21], v[20:21]
    v_pk_mul_f32 v[22:23], v[22:23], v[22:23]
    v_pk_mul_f32 v[24:25], v[24:25], v[24:25]
    v_pk_mul_f32 v[26:27], v[26:27], v[26:27]
    v_cvt_pk_bf16_f32 v36, v20, v21
    v_cvt_pk_bf16_f32 v37, v22, v23
    v_cvt_pk_bf16_f32 v38, v24, v25
    v_cvt_pk_bf16_f32 v39, v26, v27
    s_waitcnt vmcnt(3)
    v_mfma_f32_16x16x32_bf16 v[12:15], v[4:7], v[40:43], v[12:15]
    v_lshlrev_b32 v20, 16, v40
    v_and_b32 v21, s19, v40
    v_mfma_f32_16x16x32_bf16 v[16:19], v[4:7], v[36:39], v[16:19]
    v_lshlrev_b32 v22, 16, v41
    v_and_b32 v23, s19, v41
    v_lshlrev_b32 v24, 16, v42
    v_and_b32 v25, s19, v42
    v_lshlrev_b32 v26, 16, v43
    v_and_b32 v27, s19, v43
    v_pk_mul_f32 v[20:21], v[20:21], v[20:21]
    v_pk_mul_f32 v[22:23], v[22:23], v[22:23]
    v_pk_mul_f32 v[24:25], v[24:25], v[24:25]
    v_pk_mul_f32 v[26:27], v[26:27], v[26:27]
    v_cvt_pk_bf16_f32 v40, v20, v21
    v_cvt_pk_bf16_f32 v41, v22, v23
    v_cvt_pk_bf16_f32 v42, v24, v25
    v_cvt_pk_bf16_f32 v43, v26, v27
    s_waitcnt vmcnt(2)
    v_mfma_f32_16x16x32_bf16 v[12:15], v[4:7], v[44:47], v[12:15]
    v_lshlrev_b32 v20, 16, v44
    v_and_b32 v21, s19, v44
    v_mfma_f32_16x16x32_bf16 v[16:19], v[4:7], v[40:43], v[16:19]
    v_lshlrev_b32 v22, 16, v45
    v_and_b32 v23, s19, v45
    v_lshlrev_b32 v24, 16, v46
    v_and_b32 v25, s19, v46
    v_lshlrev_b32 v26, 16, v47
    v_and_b32 v27, s19, v47
    v_pk_mul_f32 v[20:21], v[20:21], v[20:21]
    v_pk_mul_f32 v[22:23], v[22:23], v[22:23]
    v_pk_mul_f32 v[24:25], v[24:25], v[24:25]
    v_pk_mul_f32 v[26:27], v[26:27], v[26:27]
    v_cvt_pk_bf16_f32 v44, v20, v21
    v_cvt_pk_bf16_f32 v45, v22, v23
    v_cvt_pk_bf16_f32 v46, v24, v25
    v_cvt_pk_bf16_f32 v47, v26, v27
    s_waitcnt vmcnt(1)
    v_mfma_f32_16x16x32_bf16 v[12:15], v[4:7], v[48:51], v[12:15]
    v_lshlrev_b32 v20, 16, v48
    v_and_b32 v21, s19, v48
    v_mfma_f32_16x16x32_bf16 v[16:19], v[4:7], v[44:47], v[16:19]
    v_lshlrev_b32 v22, 16, v49
    v_and_b32 v23, s19, v49
    v_lshlrev_b32 v24, 16, v50
    v_and_b32 v25, s19, v50
    v_lshlrev_b32 v26, 16, v51
    v_and_b32 v27, s19, v51
    v_pk_mul_f32 v[20:21], v[20:21], v[20:21]
    v_pk_mul_f32 v[22:23], v[22:23], v[22:23]
    v_pk_mul_f32 v[24:25], v[24:25], v[24:25]
    v_pk_mul_f32 v[26:27], v[26:27], v[26:27]
    v_cvt_pk_bf16_f32 v48, v20, v21
    v_cvt_pk_bf16_f32 v49, v22, v23
    v_cvt_pk_bf16_f32 v50, v24, v25
    v_cvt_pk_bf16_f32 v51, v26, v27
    s_waitcnt vmcnt(0)
    v_mfma_f32_16x16x16_bf16 v[12:15], v[8:9], v[52:53], v[12:15]
    v_lshlrev_b32 v20, 16, v52
    v_and_b32 v21, s19, v52
    v_mfma_f32_16x16x32_bf16 v[16:19], v[4:7], v[48:51], v[16:19]
    v_lshlrev_b32 v22, 16, v53
    v_and_b32 v23, s19, v53
    v_pk_mul_f32 v[20:21], v[20:21], v[20:21]
    v_pk_mul_f32 v[22:23], v[22:23], v[22:23]
    v_cvt_pk_bf16_f32 v52, v20, v21
    v_cvt_pk_bf16_f32 v53, v22, v23
    s_nop 1
    v_mfma_f32_16x16x16_bf16 v[16:19], v[8:9], v[52:53], v[16:19]
    v_cvt_pk_bf16_f32 v36, v12, v13
    v_cvt_pk_bf16_f32 v37, v14, v15
    v_lshlrev_b32 v28, 16, v36
    v_and_b32 v29, s19, v36
    v_lshlrev_b32 v30, 16, v37
    v_and_b32 v31, s19, v37
    v_pk_mul_f32 v[28:29], v[28:29], v[28:29]
    v_pk_mul_f32 v[30:31], v[30:31], v[30:31]
    v_cvt_pk_bf16_f32 v32, v28, v16
    v_cvt_pk_bf16_f32 v33, v29, v17
    v_cvt_pk_bf16_f32 v34, v30, v18
    v_cvt_pk_bf16_f32 v35, v31, v19
    v_dot2_f32_bf16 v28, v32, s16, 0
    v_dot2_f32_bf16 v29, v33, s16, 0
    v_dot2_f32_bf16 v30, v34, s16, 0
    v_dot2_f32_bf16 v31, v35, s16, 0
    s_nop 1
    v_cvt_pk_bf16_f32 v32, v28, v29
    v_cvt_pk_bf16_f32 v33, v30, v31
    v_dot2_f32_bf16 v28, v32, s17, 0
    v_dot2_f32_bf16 v28, v33, s17, v28
    s_nop 2
    v_add_f32_dpp v28, v28, v28 row_ror:8 row_mask:0xf bank_mask:0xf
    s_nop 1
    v_add_f32_dpp v28, v28, v28 row_ror:4 row_mask:0xf bank_mask:0xf
    s_nop 1
    v_add_f32_dpp v28, v28, v28 row_ror:2 row_mask:0xf bank_mask:0xf
    s_nop 1
    v_add_f32_dpp v28, v28, v28 row_ror:1 row_mask:0xf bank_mask:0xf
    s_nop 1
    v_add_f32_dpp v28, v28, v28 row_bcast:15 row_mask:0xa bank_mask:0xf
    s_mov_b64 exec, 0x10000
    v_cvt_pk_bf16_f32 v28, v28, v28
    buffer_store_short v28, v3, s[12:15], s18 offen
L_done:
    s_endpgm
.section .rodata,"a"
.p2align 6
.amdhsa_kernel standalone__fm_second_order__recsys_kernel
  .amdhsa_next_free_vgpr 56
  .amdhsa_next_free_sgpr 32
  .amdhsa_accum_offset 56
  .amdhsa_group_segment_fixed_size 0
  .amdhsa_kernarg_size 40
  .amdhsa_user_sgpr_count 2
  .amdhsa_user_sgpr_kernarg_segment_ptr 1
  .amdhsa_system_sgpr_workgroup_id_x 1
  .amdhsa_float_denorm_mode_32 3
.end_amdhsa_kernel
```
